```python
import torch

def _softmax(x, axis=-1):
    return torch.softmax(x, dim=axis)
def _gelu(x):
    return torch.nn.functional.gelu(x, approximate="tanh")
def _silu(x):
    return torch.nn.functional.silu(x)
def _sigmoid(x):
    return torch.sigmoid(x)
def _layernorm(x, axis=-1, eps=1e-5):
    m = x.mean(dim=axis, keepdim=True)
    v = x.var(dim=axis, keepdim=True, unbiased=False)
    return (x - m) / torch.sqrt(v + eps)
def _scatter_add(tgt, idx, src, axis=0):
    return tgt.clone().index_add_(axis, idx, src)
def _segment_sum(src, seg, n):
    out = torch.zeros((n,) + src.shape[1:], dtype=src.dtype)
    return out.index_add_(0, seg, src)
def _pad(x, pw):
    flat = tuple(v for pair in reversed(pw) for v in pair)
    return torch.nn.functional.pad(x, flat)

kernel_name = 'standalone__paged_block_table_kv_radixattention__sampling'

def setup_inputs():

    _w = (lambda a: (lambda t: t.to(torch.bfloat16) if t.is_floating_point() else t)(torch.as_tensor(a)))
    B, H, Hkv, Dh = 8, 16, 8, 256
    Lk = 2048
    bs = 16
    nb = max(2, Lk // bs)
    P = max(1, nb // 2)
    n_phys = P + B * (nb - P)
    shared = torch.arange(P, dtype=torch.int64)
    priv = P + torch.arange(B * (nb - P), dtype=torch.int64).reshape(B, nb - P)
    bt = torch.cat([torch.tile(shared[None, :], (B, 1)), priv], dim=1)
    ctx = nb * bs - (torch.arange(1, B + 1, dtype=torch.int64) * 2654435761) % max(1, (nb * bs - P * bs) // 2)
    return {
        "q": _w((lambda *s: torch.randn(*s, dtype=torch.bfloat16) * 0.8)(B, H, Dh)),
        "k_cache": _w((lambda *s: torch.randn(*s, dtype=torch.bfloat16) * 0.8)(n_phys, bs, Hkv, Dh)),
        "v_cache": _w((lambda *s: torch.randn(*s, dtype=torch.bfloat16) * 0.05)(n_phys, bs, Hkv, Dh)),
        "block_table": _w(bt.to(torch.int64)),
        "ctx_lens": _w(torch.as_tensor(ctx).to(torch.int64)),
    }

def reference(q, k_cache, v_cache, block_table, ctx_lens):
    B, H, Dh = q.shape
    n_phys, bs, Hkv, _ = k_cache.shape
    nb = block_table.shape[1]
    Lk = nb * bs
    rep = H // Hkv
    k = k_cache[block_table].reshape(B, Lk, Hkv, Dh)
    v = v_cache[block_table].reshape(B, Lk, Hkv, Dh)
    k = (lambda x, n, axis: torch.repeat_interleave(x, n, dim=axis))(k, rep, axis=2)
    v = (lambda x, n, axis: torch.repeat_interleave(x, n, dim=axis))(v, rep, axis=2)
    scores = torch.einsum("bhd,bkhd->bhk", q, k) * (Dh ** -0.5)
    pos = torch.arange(Lk)
    valid = pos[None, :] < ctx_lens[:, None]
    scores = torch.where(valid[:, None, :], scores, -1e9)
    p = _softmax(scores, axis=-1)
    return torch.einsum("bhk,bkhd->bhd", p, v)
```

```asm
; @launch grid=(256,1,1) block=(512,1,1) lds=163328
.amdgcn_target "amdgcn-amd-amdhsa--gfx950"
.text
.globl standalone__paged_block_table_kv_radixattention__sampling_kernel
.p2align 12
.fill 832, 4, 0xbf810000
.p2align 8
.type standalone__paged_block_table_kv_radixattention__sampling_kernel,@function
standalone__paged_block_table_kv_radixattention__sampling_kernel:
    s_load_dwordx2 s[24:25], s[0:1], 8
    s_load_dwordx2 s[52:53], s[0:1], 0
    v_readfirstlane_b32 s22, v0
    s_cmpk_ge_u32 s2, 0x100
    s_cbranch_scc1 L_end
    s_cmpk_ge_u32 s22, 0x1c0
    s_cbranch_scc1 L_hop
    s_cmpk_ge_u32 s22, 0x100
    s_cbranch_scc1 L_v
    s_and_b32 s20, s2, 7
    s_lshr_b32 s21, s2, 3
    v_bfe_u32 v20, v0, 5, 1
    v_and_b32 v21, 31, v0
    v_xor_b32 v21, v21, v20
    v_lshlrev_b32 v21, 4, v21
    v_lshl_or_b32 v22, v20, 12, v21
    s_lshl_b32 s3, s20, 9
    v_or_b32 v12, s3, v22
    s_lshr_b32 s60, s22, 6
    s_mov_b32 s35, 63
    s_cmp_lt_u32 s21, 8
    s_cbranch_scc0 L_gp
    s_mul_i32 s34, s21, 69
    s_cmp_ge_u32 s21, 6
    s_cselect_b32 s33, 32, 0
    s_sub_u32 s34, s34, s33
    s_add_u32 s34, s34, s60
    s_addk_i32 s34, 85
    s_add_u32 s36, s21, 1
    s_and_b32 s33, s36, 7
    s_lshl4_add_u32 s33, s60, s33
    s_sub_u32 s33, 20, s33
    s_mov_b32 s38, 0
    s_branch L_k1
L_gp:
    s_sub_u32 s33, s21, 7
    s_mul_i32 s33, s33, 13981120
    s_lshr_b32 s36, s33, 16
    s_sub_u32 s33, s33, 13981120
    s_lshr_b32 s33, s33, 16
    s_add_u32 s34, s36, 15
    s_lshr_b32 s34, s34, 4
    s_sub_u32 s36, 0, s36
    s_and_b32 s36, s36, 15
    s_add_u32 s34, s34, s60
    s_sub_u32 s34, s34, 16
    s_lshl_b32 s3, s34, 4
    s_sub_u32 s33, s33, s3
    s_cmpk_ge_i32 s34, 64
    s_cmovk_i32 s35, 22
    s_cmpk_ge_i32 s34, 87
    s_cmovk_i32 s35, 2651
    s_cmpk_ge_i32 s34, 115
    s_cmovk_i32 s35, 4960
    s_cmpk_ge_i32 s34, 148
    s_cmovk_i32 s35, 6948
    s_cmpk_ge_i32 s34, 185
    s_cmovk_i32 s35, 8681
    s_cmpk_ge_i32 s34, 227
    s_cmovk_i32 s35, 10094
    s_cmpk_ge_i32 s34, 274
    s_cmovk_i32 s35, 11155
    s_cmpk_ge_i32 s34, 294
    s_cmovk_i32 s35, 13977
    s_lshr_b32 s3, s35, 6
    s_add_u32 s34, s34, s3
    s_and_b32 s35, s35, 63
    s_bfe_u32 s38, s34, 0x30006
    s_add_u32 s38, s38, 12
    s_and_b32 s38, s38, 15
    s_cmp_eq_u32 s35, 63
    s_cselect_b32 s38, 0, s38
L_k1:
    s_sub_u32 s39, 63, s35
    s_andn2_b32 s3, s34, 63
    s_add_u32 s35, s35, s3
    s_lshl_b32 s63, s22, 7
    s_addk_i32 s63, 32256
    s_mov_b32 s27, 0x20000
    s_cmp_eq_u32 s34, s35
    s_cselect_b32 s3, s38, 0
    s_sub_u32 s3, 16, s3
    s_max_i32 s48, s33, 0
    s_max_u32 s3, s3, s48
    s_lshl4_add_u32 s3, s34, s3
    s_lshl_b32 s64, s3, 12
    s_lshl4_add_u32 s3, s34, s48
    s_lshl_b32 s48, s3, 12
    s_cmp_lt_i32 s33, 16
    s_cselect_b32 s48, s48, 0
    s_cselect_b32 s64, s64, 0
    s_cbranch_scc0 L_k0skip
    s_waitcnt lgkmcnt(0)
    s_mov_b32 m0, s63
    s_mov_b32 s26, s64
    buffer_load_dwordx4 v12, s[24:27], s48 offen nt lds
    v_xor_b32 v13, 0x2020, v12
    v_subrev_u32 v13, 1024, v13
    buffer_load_dwordx4 v13, s[24:27], s48 offen offset:1024 nt lds
    v_xor_b32 v14, 0x4040, v12
    v_subrev_u32 v14, 2048, v14
    buffer_load_dwordx4 v14, s[24:27], s48 offen offset:2048 nt lds
    v_xor_b32 v15, 0x6060, v12
    v_subrev_u32 v15, 3072, v15
    buffer_load_dwordx4 v15, s[24:27], s48 offen offset:3072 nt lds
    v_xor_b32 v16, 0x8080, v12
    s_addk_i32 m0, 0x1000
    s_nop 0
    buffer_load_dwordx4 v16, s[24:27], s48 offen nt lds
    v_xor_b32 v17, 0xa0a0, v12
    v_subrev_u32 v17, 1024, v17
    buffer_load_dwordx4 v17, s[24:27], s48 offen offset:1024 nt lds
    v_xor_b32 v18, 0xc0c0, v12
    v_subrev_u32 v18, 2048, v18
    buffer_load_dwordx4 v18, s[24:27], s48 offen offset:2048 nt lds
    v_xor_b32 v19, 0xe0e0, v12
    v_subrev_u32 v19, 3072, v19
    buffer_load_dwordx4 v19, s[24:27], s48 offen offset:3072 nt lds
    s_branch L_k0done
L_k0skip:
    v_xor_b32 v13, 0x2020, v12
    v_subrev_u32 v13, 1024, v13
    v_xor_b32 v14, 0x4040, v12
    v_subrev_u32 v14, 2048, v14
    v_xor_b32 v15, 0x6060, v12
    v_subrev_u32 v15, 3072, v15
    v_xor_b32 v16, 0x8080, v12
    v_xor_b32 v17, 0xa0a0, v12
    v_subrev_u32 v17, 1024, v17
    v_xor_b32 v18, 0xc0c0, v12
    v_subrev_u32 v18, 2048, v18
    v_xor_b32 v19, 0xe0e0, v12
    v_subrev_u32 v19, 3072, v19
    s_waitcnt lgkmcnt(0)
L_k0done:
    v_lshl_or_b32 v21, v20, 9, v21
    s_mul_i32 s3, s22, 0x101
    v_xor_b32 v21, s3, v21
    v_xor_b32 v22, 0x2020, v21
    v_subrev_u32 v22, 0x400, v22
    s_lshl_b32 s3, s22, 5
    s_add_u32 m0, s3, 24064
    s_mov_b32 s54, 0x10000
    s_mov_b32 s55, 0x20000
    s_lshl_b32 s3, s20, 10
    buffer_load_dwordx4 v21, s[52:55], s3 offen lds
    buffer_load_dwordx4 v22, s[52:55], s3 offen offset:1024 lds
    s_load_dwordx16 s[4:19], s[0:1], 0
    s_lshr_b32 s23, s22, 4
    s_cmp_eq_u32 s60, 3
    s_cselect_b32 s36, s36, 0
    s_add_u32 s34, s34, 4
    s_cmp_gt_i32 s34, s35
    s_cselect_b32 s3, s39, 0
    s_cselect_b32 s39, 0, s39
    s_add_u32 s34, s34, s3
    s_sub_u32 s33, s33, 64
    s_cmp_eq_u32 s34, s35
    s_cselect_b32 s3, s38, 0
    s_sub_u32 s3, 16, s3
    s_max_i32 s49, s33, 0
    s_max_u32 s3, s3, s49
    s_lshl4_add_u32 s3, s34, s3
    s_lshl_b32 s65, s3, 12
    s_lshl4_add_u32 s3, s34, s49
    s_lshl_b32 s49, s3, 12
    s_cmp_lt_i32 s33, 16
    s_cselect_b32 s49, s49, 0
    s_cselect_b32 s65, s65, 0
    s_add_u32 s34, s34, 4
    s_cmp_gt_i32 s34, s35
    s_cselect_b32 s3, s39, 0
    s_cselect_b32 s39, 0, s39
    s_add_u32 s34, s34, s3
    s_sub_u32 s33, s33, 64
    s_cmp_eq_u32 s34, s35
    s_cselect_b32 s3, s38, 0
    s_sub_u32 s3, 16, s3
    s_max_i32 s50, s33, 0
    s_max_u32 s3, s3, s50
    s_lshl4_add_u32 s3, s34, s3
    s_lshl_b32 s66, s3, 12
    s_lshl4_add_u32 s3, s34, s50
    s_lshl_b32 s50, s3, 12
    s_cmp_lt_i32 s33, 16
    s_cselect_b32 s50, s50, 0
    s_cselect_b32 s66, s66, 0
    s_add_u32 s34, s34, 4
    s_cmp_gt_i32 s34, s35
    s_cselect_b32 s3, s39, 0
    s_cselect_b32 s39, 0, s39
    s_add_u32 s34, s34, s3
    s_sub_u32 s33, s33, 64
    s_cmp_eq_u32 s34, s35
    s_cselect_b32 s3, s38, 0
    s_max_u32 s3, s3, s36
    s_sub_u32 s3, 16, s3
    s_max_i32 s51, s33, 0
    s_max_u32 s3, s3, s51
    s_lshl4_add_u32 s3, s34, s3
    s_lshl_b32 s67, s3, 12
    s_lshl4_add_u32 s3, s34, s51
    s_lshl_b32 s51, s3, 12
    s_cmp_lt_i32 s33, 16
    s_cselect_b32 s51, s51, 0
    s_cselect_b32 s67, s67, 0
    v_and_b32 v0, 63, v0
    v_and_b32 v1, 15, v0
    v_lshrrev_b32 v2, 4, v0
    v_lshrrev_b32 v3, 1, v1
    v_xor_b32 v20, v2, v1
    v_lshlrev_b32 v20, 4, v20
    v_lshl_or_b32 v20, v1, 9, v20
    v_xor_b32 v21, 64, v20
    v_xor_b32 v22, 128, v20
    v_xor_b32 v23, 192, v20
    v_lshlrev_b32 v28, 5, v1
    v_mov_b32 v123, 0
    v_mov_b32 v30, 0xf149f2ca
    v_mov_b32 v142, 0
    s_mov_b32 s62, 1
    s_mov_b32 s37, 65536
L_k12:
    s_cmp_lg_u32 s65, 0
    s_cbranch_scc1 L_kq1
    s_waitcnt vmcnt(0)
L_kq1:
    s_cmp_eq_u32 s65, 0
    s_cbranch_scc1 L_ks1
    s_add_u32 m0, s63, 32768
    s_mov_b32 s26, s65
    buffer_load_dwordx4 v12, s[24:27], s49 offen nt lds
    buffer_load_dwordx4 v13, s[24:27], s49 offen offset:1024 nt lds
    buffer_load_dwordx4 v14, s[24:27], s49 offen offset:2048 nt lds
    buffer_load_dwordx4 v15, s[24:27], s49 offen offset:3072 nt lds
    s_addk_i32 m0, 0x1000
    s_nop 0
    buffer_load_dwordx4 v16, s[24:27], s49 offen nt lds
    buffer_load_dwordx4 v17, s[24:27], s49 offen offset:1024 nt lds
    buffer_load_dwordx4 v18, s[24:27], s49 offen offset:2048 nt lds
    buffer_load_dwordx4 v19, s[24:27], s49 offen offset:3072 nt lds
L_ks1:
    s_cmp_eq_u32 s66, 0
    s_cbranch_scc1 L_ks2
    s_add_u32 m0, s63, 65536
    s_mov_b32 s26, s66
    buffer_load_dwordx4 v12, s[24:27], s50 offen nt lds
    buffer_load_dwordx4 v13, s[24:27], s50 offen offset:1024 nt lds
    buffer_load_dwordx4 v14, s[24:27], s50 offen offset:2048 nt lds
    buffer_load_dwordx4 v15, s[24:27], s50 offen offset:3072 nt lds
    s_addk_i32 m0, 0x1000
    s_nop 0
    buffer_load_dwordx4 v16, s[24:27], s50 offen nt lds
    buffer_load_dwordx4 v17, s[24:27], s50 offen offset:1024 nt lds
    buffer_load_dwordx4 v18, s[24:27], s50 offen offset:2048 nt lds
    buffer_load_dwordx4 v19, s[24:27], s50 offen offset:3072 nt lds
L_ks2:
    s_cmp_eq_u32 s67, 0
    s_cbranch_scc1 L_ks3
    s_add_u32 m0, s63, 98304
    s_mov_b32 s26, s67
    buffer_load_dwordx4 v12, s[24:27], s51 offen nt lds
    buffer_load_dwordx4 v13, s[24:27], s51 offen offset:1024 nt lds
    buffer_load_dwordx4 v14, s[24:27], s51 offen offset:2048 nt lds
    buffer_load_dwordx4 v15, s[24:27], s51 offen offset:3072 nt lds
    s_addk_i32 m0, 0x1000
    s_nop 0
    buffer_load_dwordx4 v16, s[24:27], s51 offen nt lds
    buffer_load_dwordx4 v17, s[24:27], s51 offen offset:1024 nt lds
    buffer_load_dwordx4 v18, s[24:27], s51 offen offset:2048 nt lds
    buffer_load_dwordx4 v19, s[24:27], s51 offen offset:3072 nt lds
L_ks3:
    s_waitcnt vmcnt(24)
    s_barrier
    ds_read_b128 v[4:7], v28 offset:4096
    ds_read_b128 v[8:11], v28 offset:4112
    s_cmp_eq_u32 s62, 0
    s_cbranch_scc1 L_knoq
    ds_read_b128 v[32:35], v20 offset:24064
    ds_read_b128 v[36:39], v21 offset:24064
    ds_read_b128 v[40:43], v22 offset:24064
    ds_read_b128 v[44:47], v23 offset:24064
    ds_read_b128 v[48:51], v20 offset:24320
    ds_read_b128 v[52:55], v21 offset:24320
    ds_read_b128 v[56:59], v22 offset:24320
    ds_read_b128 v[60:63], v23 offset:24320
    v_add_u32 v20, s63, v20
    v_add_u32 v24, 0x10000, v20
    v_add_u32 v21, s63, v21
    v_add_u32 v25, 0x10000, v21
    v_add_u32 v22, s63, v22
    v_add_u32 v26, 0x10000, v22
    v_add_u32 v23, s63, v23
    v_add_u32 v27, 0x10000, v23
L_knoq:
    s_waitcnt lgkmcnt(0)
    ds_read_b128 v[64:67], v20 offset:0
    ds_read_b128 v[68:71], v21 offset:0
    ds_read_b128 v[72:75], v22 offset:0
    ds_read_b128 v[76:79], v23 offset:0
    ds_read_b128 v[80:83], v20 offset:256
    ds_read_b128 v[84:87], v21 offset:256
    ds_read_b128 v[88:91], v22 offset:256
    ds_read_b128 v[92:95], v23 offset:256
    s_waitcnt lgkmcnt(7)
    v_mfma_f32_16x16x32_bf16 v[96:99], v[64:67], v[32:35], 0
    s_waitcnt lgkmcnt(6)
    v_mfma_f32_16x16x32_bf16 v[96:99], v[68:71], v[36:39], v[96:99]
    s_waitcnt lgkmcnt(5)
    v_mfma_f32_16x16x32_bf16 v[96:99], v[72:75], v[40:43], v[96:99]
    s_waitcnt lgkmcnt(4)
    v_mfma_f32_16x16x32_bf16 v[96:99], v[76:79], v[44:47], v[96:99]
    s_waitcnt lgkmcnt(3)
    v_mfma_f32_16x16x32_bf16 v[96:99], v[80:83], v[48:51], v[96:99]
    s_waitcnt lgkmcnt(2)
    v_mfma_f32_16x16x32_bf16 v[96:99], v[84:87], v[52:55], v[96:99]
    s_waitcnt lgkmcnt(1)
    v_mfma_f32_16x16x32_bf16 v[96:99], v[88:91], v[56:59], v[96:99]
    s_waitcnt lgkmcnt(0)
    v_mfma_f32_16x16x32_bf16 v[96:99], v[92:95], v[60:63], v[96:99]
    v_cmp_ne_u32 s[44:45], 0, v9
    s_mov_b32 s3, s60
    v_readlane_b32 s72, v4, s3
    v_readlane_b32 s68, v5, s3
    v_readlane_b32 s56, v6, s3
    s_add_u32 s3, s3, 4
    v_readlane_b32 s73, v4, s3
    v_readlane_b32 s69, v5, s3
    v_readlane_b32 s57, v6, s3
    s_add_u32 s3, s3, 4
    v_readlane_b32 s74, v4, s3
    v_readlane_b32 s70, v5, s3
    v_readlane_b32 s58, v6, s3
    s_add_u32 s3, s3, 4
    v_readlane_b32 s75, v4, s3
    v_readlane_b32 s71, v5, s3
    v_readlane_b32 s59, v6, s3
    v_readfirstlane_b32 s46, v10
    v_readfirstlane_b32 s40, v11
    s_xor_b64 s[68:69], s[64:65], s[68:69]
    s_xor_b64 s[70:71], s[66:67], s[70:71]
    s_xor_b64 s[72:73], s[48:49], s[72:73]
    s_xor_b64 s[74:75], s[50:51], s[74:75]
    s_or_b64 s[68:69], s[68:69], s[70:71]
    s_or_b64 s[72:73], s[72:73], s[74:75]
    s_or_b64 s[68:69], s[68:69], s[72:73]
    s_cbranch_scc0 L_kok
    v_mov_b32 v126, 1
    ds_write_b32 v123, v126 offset:5248
L_kok:
    s_waitcnt vmcnt(16)
    ds_read_b128 v[64:67], v20 offset:32768
    ds_read_b128 v[68:71], v21 offset:32768
    ds_read_b128 v[72:75], v22 offset:32768
    ds_read_b128 v[76:79], v23 offset:32768
    ds_read_b128 v[80:83], v20 offset:33024
    ds_read_b128 v[84:87], v21 offset:33024
    ds_read_b128 v[88:91], v22 offset:33024
    ds_read_b128 v[92:95], v23 offset:33024
    s_waitcnt lgkmcnt(7)
    v_mfma_f32_16x16x32_bf16 v[100:103], v[64:67], v[32:35], 0
    s_waitcnt lgkmcnt(6)
    v_mfma_f32_16x16x32_bf16 v[100:103], v[68:71], v[36:39], v[100:103]
    s_waitcnt lgkmcnt(5)
    v_mfma_f32_16x16x32_bf16 v[100:103], v[72:75], v[40:43], v[100:103]
    s_waitcnt lgkmcnt(4)
    v_mfma_f32_16x16x32_bf16 v[100:103], v[76:79], v[44:47], v[100:103]
    s_waitcnt lgkmcnt(3)
    v_mfma_f32_16x16x32_bf16 v[100:103], v[80:83], v[48:51], v[100:103]
    s_waitcnt lgkmcnt(2)
    v_mfma_f32_16x16x32_bf16 v[100:103], v[84:87], v[52:55], v[100:103]
    s_waitcnt lgkmcnt(1)
    v_mfma_f32_16x16x32_bf16 v[100:103], v[88:91], v[56:59], v[100:103]
    s_waitcnt lgkmcnt(0)
    v_mfma_f32_16x16x32_bf16 v[100:103], v[92:95], v[60:63], v[100:103]
    s_barrier
    ds_read_b32 v127, v123 offset:5248
    s_mul_i32 s3, s20, 221184
    s_mul_i32 s33, s21, 27648
    s_sub_u32 s34, s21, 8
    s_mulk_i32 s34, 1152
    s_mov_b32 s30, 194688
    s_cmp_lt_u32 s21, 8
    s_cselect_b32 s33, s33, s34
    s_cselect_b32 s30, 27648, s30
    s_add_u32 s3, s3, s33
    s_add_u32 s28, s18, s3
    s_addc_u32 s29, s19, 0
    s_mov_b32 s31, 0x20000
    v_mov_b32 v121, 0xff800000
    v_add_u32 v122, 1, v3
    v_lshlrev_b32 v120, 2, v2
    s_waitcnt lgkmcnt(0)
    v_cmp_ne_u32 vcc, 0, v127
    s_nop 0
    s_cbranch_vccnz L_kx
    s_waitcnt vmcnt(8)
    ds_read_b128 v[64:67], v24 offset:0
    ds_read_b128 v[68:71], v25 offset:0
    ds_read_b128 v[72:75], v26 offset:0
    ds_read_b128 v[76:79], v27 offset:0
    ds_read_b128 v[80:83], v24 offset:256
    ds_read_b128 v[84:87], v25 offset:256
    ds_read_b128 v[88:91], v26 offset:256
    ds_read_b128 v[92:95], v27 offset:256
    s_waitcnt lgkmcnt(7)
    v_mfma_f32_16x16x32_bf16 v[104:107], v[64:67], v[32:35], 0
    s_waitcnt lgkmcnt(6)
    v_mfma_f32_16x16x32_bf16 v[104:107], v[68:71], v[36:39], v[104:107]
    s_waitcnt lgkmcnt(5)
    v_mfma_f32_16x16x32_bf16 v[104:107], v[72:75], v[40:43], v[104:107]
    s_waitcnt lgkmcnt(4)
    v_mfma_f32_16x16x32_bf16 v[104:107], v[76:79], v[44:47], v[104:107]
    s_waitcnt lgkmcnt(3)
    v_mfma_f32_16x16x32_bf16 v[104:107], v[80:83], v[48:51], v[104:107]
    s_waitcnt lgkmcnt(2)
    v_mfma_f32_16x16x32_bf16 v[104:107], v[84:87], v[52:55], v[104:107]
    s_waitcnt lgkmcnt(1)
    v_mfma_f32_16x16x32_bf16 v[104:107], v[88:91], v[56:59], v[104:107]
    s_waitcnt lgkmcnt(0)
    v_mfma_f32_16x16x32_bf16 v[104:107], v[92:95], v[60:63], v[104:107]
    s_and_b32 s3, s56, 15
    s_lshr_b32 s33, s56, 9
    s_bfe_u32 s34, s56, 0x50004
    v_cmp_eq_u32 vcc, s3, v122
    v_subrev_u32 v126, s33, v7
    v_min_i32 v126, s34, v126
    v_sub_u32 v126, v126, v120
    s_cmp_eq_u32 s3, 0
    s_cselect_b64 vcc, -1, vcc
    v_cndmask_b32 v126, 0, v126, vcc
    v_cmp_lt_i32 s[72:73], 0, v126
    v_cmp_lt_i32 s[74:75], 1, v126
    v_cmp_lt_i32 s[76:77], 2, v126
    v_cmp_lt_i32 s[78:79], 3, v126
    v_cvt_pk_bf16_f32 v96, 0, v96
    v_cvt_pk_bf16_f32 v97, 0, v97
    v_cvt_pk_bf16_f32 v98, 0, v98
    v_cvt_pk_bf16_f32 v99, 0, v99
    v_mul_f32 v96, v96, v8
    v_mul_f32 v97, v97, v8
    v_mul_f32 v98, v98, v8
    v_mul_f32 v99, v99, v8
    v_cndmask_b32 v96, v121, v96, s[72:73]
    v_cndmask_b32 v97, v121, v97, s[74:75]
    v_cndmask_b32 v98, v121, v98, s[76:77]
    v_cndmask_b32 v99, v121, v99, s[78:79]
    s_and_b32 s3, s57, 15
    s_lshr_b32 s33, s57, 9
    s_bfe_u32 s34, s57, 0x50004
    v_cmp_eq_u32 vcc, s3, v122
    v_subrev_u32 v126, s33, v7
    v_min_i32 v126, s34, v126
    v_sub_u32 v126, v126, v120
    s_cmp_eq_u32 s3, 0
    s_cselect_b64 vcc, -1, vcc
    v_cndmask_b32 v126, 0, v126, vcc
    v_cmp_lt_i32 s[72:73], 0, v126
    v_cmp_lt_i32 s[74:75], 1, v126
    v_cmp_lt_i32 s[76:77], 2, v126
    v_cmp_lt_i32 s[78:79], 3, v126
    v_cvt_pk_bf16_f32 v100, 0, v100
    v_cvt_pk_bf16_f32 v101, 0, v101
    v_cvt_pk_bf16_f32 v102, 0, v102
    v_cvt_pk_bf16_f32 v103, 0, v103
    v_mul_f32 v100, v100, v8
    v_mul_f32 v101, v101, v8
    v_mul_f32 v102, v102, v8
    v_mul_f32 v103, v103, v8
    v_cndmask_b32 v100, v121, v100, s[72:73]
    v_cndmask_b32 v101, v121, v101, s[74:75]
    v_cndmask_b32 v102, v121, v102, s[76:77]
    v_cndmask_b32 v103, v121, v103, s[78:79]
    s_and_b32 s3, s58, 15
    s_lshr_b32 s33, s58, 9
    s_bfe_u32 s34, s58, 0x50004
    v_cmp_eq_u32 vcc, s3, v122
    v_subrev_u32 v126, s33, v7
    v_min_i32 v126, s34, v126
    v_sub_u32 v126, v126, v120
    s_cmp_eq_u32 s3, 0
    s_cselect_b64 vcc, -1, vcc
    v_cndmask_b32 v126, 0, v126, vcc
    v_cmp_lt_i32 s[72:73], 0, v126
    v_cmp_lt_i32 s[74:75], 1, v126
    v_cmp_lt_i32 s[76:77], 2, v126
    v_cmp_lt_i32 s[78:79], 3, v126
    v_cvt_pk_bf16_f32 v104, 0, v104
    v_cvt_pk_bf16_f32 v105, 0, v105
    v_cvt_pk_bf16_f32 v106, 0, v106
    v_cvt_pk_bf16_f32 v107, 0, v107
    v_mul_f32 v104, v104, v8
    v_mul_f32 v105, v105, v8
    v_mul_f32 v106, v106, v8
    v_mul_f32 v107, v107, v8
    v_cndmask_b32 v104, v121, v104, s[72:73]
    v_cndmask_b32 v105, v121, v105, s[74:75]
    v_cndmask_b32 v106, v121, v106, s[76:77]
    v_cndmask_b32 v107, v121, v107, s[78:79]
    v_max3_f32 v128, v30, v96, v97
    v_max3_f32 v128, v128, v98, v99
    v_max3_f32 v128, v128, v100, v101
    v_max3_f32 v128, v128, v102, v103
    v_max3_f32 v128, v128, v104, v105
    v_max3_f32 v128, v128, v106, v107
    v_lshlrev_b32 v31, 4, v1
    v_add_u32 v130, s23, v31
    v_lshlrev_b32 v131, 4, v0
    s_mul_i32 s3, s60, 0x208
    s_and_b32 s3, s3, 0x408
    s_add_u32 s3, s3, 155136
    v_add_u32 v131, s3, v131
    s_waitcnt vmcnt(0)
    ds_read_b128 v[64:67], v24 offset:32768
    ds_read_b128 v[68:71], v25 offset:32768
    ds_read_b128 v[72:75], v26 offset:32768
    ds_read_b128 v[76:79], v27 offset:32768
    ds_read_b128 v[80:83], v24 offset:33024
    ds_read_b128 v[84:87], v25 offset:33024
    ds_read_b128 v[88:91], v26 offset:33024
    ds_read_b128 v[92:95], v27 offset:33024
    s_waitcnt lgkmcnt(7)
    v_mfma_f32_16x16x32_bf16 v[108:111], v[64:67], v[32:35], 0
    s_waitcnt lgkmcnt(6)
    v_mfma_f32_16x16x32_bf16 v[108:111], v[68:71], v[36:39], v[108:111]
    s_waitcnt lgkmcnt(5)
    v_mfma_f32_16x16x32_bf16 v[108:111], v[72:75], v[40:43], v[108:111]
    s_waitcnt lgkmcnt(4)
    v_mfma_f32_16x16x32_bf16 v[108:111], v[76:79], v[44:47], v[108:111]
    s_waitcnt lgkmcnt(3)
    v_mfma_f32_16x16x32_bf16 v[108:111], v[80:83], v[48:51], v[108:111]
    s_waitcnt lgkmcnt(2)
    v_mfma_f32_16x16x32_bf16 v[108:111], v[84:87], v[52:55], v[108:111]
    s_waitcnt lgkmcnt(1)
    v_mfma_f32_16x16x32_bf16 v[108:111], v[88:91], v[56:59], v[108:111]
    s_waitcnt lgkmcnt(0)
    v_mfma_f32_16x16x32_bf16 v[108:111], v[92:95], v[60:63], v[108:111]
    s_and_b32 s3, s59, 15
    s_lshr_b32 s33, s59, 9
    s_bfe_u32 s34, s59, 0x50004
    v_cmp_eq_u32 vcc, s3, v122
    v_subrev_u32 v126, s33, v7
    v_min_i32 v126, s34, v126
    v_sub_u32 v126, v126, v120
    s_cmp_eq_u32 s3, 0
    s_cselect_b64 vcc, -1, vcc
    v_cndmask_b32 v126, 0, v126, vcc
    v_cmp_lt_i32 s[72:73], 0, v126
    v_cmp_lt_i32 s[74:75], 1, v126
    v_cmp_lt_i32 s[76:77], 2, v126
    v_cmp_lt_i32 s[78:79], 3, v126
    v_cvt_pk_bf16_f32 v108, 0, v108
    v_cvt_pk_bf16_f32 v109, 0, v109
    v_cvt_pk_bf16_f32 v110, 0, v110
    v_cvt_pk_bf16_f32 v111, 0, v111
    v_mul_f32 v108, v108, v8
    v_mul_f32 v109, v109, v8
    v_mul_f32 v110, v110, v8
    v_mul_f32 v111, v111, v8
    v_cndmask_b32 v108, v121, v108, s[72:73]
    v_cndmask_b32 v109, v121, v109, s[74:75]
    v_cndmask_b32 v110, v121, v110, s[76:77]
    v_cndmask_b32 v111, v121, v111, s[78:79]
    v_max3_f32 v128, v128, v108, v109
    v_max3_f32 v128, v128, v110, v111
    v_mov_b32 v129, v128
    s_nop 1
    v_permlane32_swap_b32 v128, v129
    v_max_f32 v128, v128, v129
    v_mov_b32 v129, v128
    s_nop 1
    v_permlane16_swap_b32 v128, v129
    v_max_f32 v128, v128, v129
    ds_write_b32 v130, v128 offset:4608
    s_lshl_b32 s3, s20, 5
    v_lshl_add_u32 v139, v3, 2, s3
    s_cmp_ge_u32 s21, 8
    s_cselect_b32 s3, s22, 1
    s_cmp_lg_u32 s3, 0
    s_cbranch_scc1 L_kmax
    global_load_dword v141, v139, s[16:17] sc1
L_kmax:
    ds_read_b128 v[132:135], v31 offset:4608
    s_waitcnt lgkmcnt(0)
    v_max3_u32 v129, v132, v133, v134
    v_max_u32 v129, v129, v135
    v_cmp_eq_u32 vcc, -1, v129
    s_nop 0
    s_cbranch_vccnz L_kmax
    v_max3_f32 v128, v132, v133, v134
    v_max_f32 v129, v128, v135
    v_sub_f32 v96, v96, v129
    v_sub_f32 v97, v97, v129
    v_sub_f32 v98, v98, v129
    v_sub_f32 v99, v99, v129
    v_sub_f32 v100, v100, v129
    v_sub_f32 v101, v101, v129
    v_sub_f32 v102, v102, v129
    v_sub_f32 v103, v103, v129
    v_sub_f32 v104, v104, v129
    v_sub_f32 v105, v105, v129
    v_sub_f32 v106, v106, v129
    v_sub_f32 v107, v107, v129
    v_sub_f32 v108, v108, v129
    v_sub_f32 v109, v109, v129
    v_sub_f32 v110, v110, v129
    v_sub_f32 v111, v111, v129
    v_sub_f32 v128, v30, v129
    v_exp_f32 v96, v96
    v_exp_f32 v97, v97
    v_exp_f32 v98, v98
    v_exp_f32 v99, v99
    v_exp_f32 v100, v100
    v_exp_f32 v101, v101
    v_exp_f32 v102, v102
    v_exp_f32 v103, v103
    v_exp_f32 v104, v104
    v_exp_f32 v105, v105
    v_exp_f32 v106, v106
    v_exp_f32 v107, v107
    v_exp_f32 v108, v108
    v_exp_f32 v109, v109
    v_exp_f32 v110, v110
    v_exp_f32 v111, v111
    v_exp_f32 v128, v128
    v_cvt_pk_bf16_f32 v112, v96, v97
    v_cvt_pk_bf16_f32 v113, v98, v99
    v_cvt_pk_bf16_f32 v114, v100, v101
    v_cvt_pk_bf16_f32 v115, v102, v103
    v_cvt_pk_bf16_f32 v116, v104, v105
    v_cvt_pk_bf16_f32 v117, v106, v107
    v_cvt_pk_bf16_f32 v118, v108, v109
    v_cvt_pk_bf16_f32 v119, v110, v111
    ds_write_b64 v131, v[112:113] offset:0
    ds_write_b64 v131, v[114:115] offset:2048
    ds_write_b64 v131, v[116:117] offset:4096
    ds_write_b64 v131, v[118:119] offset:6144
    v_lshlrev_b32 v132, 3, v1
    ds_write_b64 v132, v[128:129] offset:5120
    v_mov_b32 v30, v129
    v_add_f32 v96, v96, v104
    v_add_f32 v97, v97, v105
    v_add_f32 v98, v98, v106
    v_add_f32 v99, v99, v107
    v_add_f32 v100, v100, v108
    v_add_f32 v101, v101, v109
    v_add_f32 v102, v102, v110
    v_add_f32 v103, v103, v111
    v_add_f32 v96, v96, v100
    v_add_f32 v97, v97, v101
    v_add_f32 v98, v98, v102
    v_add_f32 v99, v99, v103
    v_add_f32 v96, v96, v97
    v_add_f32 v98, v98, v99
    v_add_f32 v96, v96, v98
    v_mov_b32 v97, v96
    s_nop 1
    v_permlane32_swap_b32 v96, v97
    v_add_f32 v96, v96, v97
    v_mov_b32 v97, v96
    s_nop 1
    v_permlane16_swap_b32 v96, v97
    v_add_f32 v96, v96, v97
    ds_write_b32 v130, v96 offset:4864
    v_and_b32 v126, 1, v0
    s_lshl_b32 s3, s21, 1
    v_add_lshl_u32 v127, v126, s3, 4
    s_cmp_lt_u32 s21, 8
    s_cselect_b64 vcc, -1, 0
    v_cndmask_b32 v31, v31, v127, vcc
    v_lshrrev_b32 v130, 1, v31
    s_waitcnt lgkmcnt(0)
    s_barrier
    ds_read_b64 v[128:129], v130 offset:5120
    ds_read_b128 v[132:135], v31 offset:4864
    v_lshrrev_b32 v100, 1, v0
    v_lshrrev_b32 v101, v100, v10
    v_and_b32 v101, 1, v101
    v_cmp_ne_u32 s[52:53], 0, v101
    v_mul_u32_u24 v101, 1152, v100
    s_waitcnt lgkmcnt(0)
    v_fma_f32 v142, v142, v128, v132
    v_add_f32 v133, v133, v134
    v_add_f32 v142, v142, v135
    v_mov_b32 v140, v129
    v_add_f32 v142, v142, v133
    s_cmp_lg_u32 s40, 0
    s_cbranch_scc1 L_kx
    s_cmp_lg_u32 s23, 12
    s_cbranch_scc1 L_knt
    s_and_b32 s3, s21, 7
    s_lshl3_add_u32 s3, s20, s3
    s_mulk_i32 s3, 27648
    s_lshr_b32 s33, s21, 3
    s_lshl_b32 s33, s33, 8
    s_add_u32 s3, s3, s33
    v_lshl_add_u32 v127, v126, 7, v101
    v_add_u32 v127, s3, v127
    s_mov_b64 exec, s[52:53]
    s_cbranch_execz L_knx
    global_load_dword v127, v127, s[18:19] sc1
L_knx:
    s_mov_b64 exec, -1
L_knt:
    s_cmp_lt_u32 s21, 8
    s_cbranch_scc1 L_k_cons
    s_cmp_lg_u32 s22, 0
    s_cbranch_scc1 L_fin
    v_lshlrev_b32 v126, 4, v126
    s_movk_i32 s3, 27648
    v_mad_u32_u24 v29, v3, s3, v126
L_kp_flag:
    s_waitcnt vmcnt(0)
    v_cmp_eq_u32 vcc, 0, v141
    s_getreg_b32 s3, hwreg(HW_REG_XCC_ID, 0, 4)
    s_and_b64 vcc, vcc, s[44:45]
    s_cbranch_scc1 L_kp_reflag
L_kp_flagok:
    s_add_u32 s3, s3, 1
    v_and_b32 v126, 0xff, v141
    v_mov_b32 v143, v141
    v_cmp_ne_u32 vcc, s3, v126
    v_mov_b32 v126, 1
    s_and_b64 vcc, vcc, s[44:45]
    s_cbranch_scc1 L_kp_far
    ds_write_b32 v123, v126 offset:5252
    s_and_b32 exec_lo, s44, 0xffff
    s_mov_b32 exec_hi, 0
    s_cbranch_execz L_kp_end
    buffer_store_dwordx4 v[140:143], v29, s[28:31], 0 offen offset:1024
L_kp_end:
    s_waitcnt lgkmcnt(0)
    s_barrier
    s_endpgm
.p2align 12
L_hop:
    s_branch L_hop2
L_k_cons:
    v_lshl_add_u32 v29, v126, 4, v101
    v_cndmask_b32 v29, 2.0, v29, s[52:53]
    ds_read_b32 v141, v123 offset:5252
    v_mbcnt_lo_u32_b32 v128, s46, 0
    s_mov_b32 vcc_lo, s46
    s_mov_b32 vcc_hi, 0
    v_cndmask_b32 v128, 63, v128, vcc
    v_lshlrev_b32 v128, 2, v128
    v_add_u32 v129, 1, v0
    ds_permute_b32 v154, v128, v129
    s_bcnt1_i32_b32 s47, s46
    v_lshlrev_b32 v155, 2, v2
    s_lshl_b32 s3, s23, 6
    v_lshl_add_u32 v158, v1, 4, s3
    v_bfe_u32 v160, v0, 3, 1
    v_and_b32 v130, 1, v2
    v_lshl_add_u32 v130, v160, 1, v130
    v_and_b32 v131, 7, v0
    v_lshl_add_u32 v157, v130, 3, v131
    s_lshl_b32 s3, s23, 7
    v_lshl_add_u32 v157, v157, 4, s3
    v_mov_b32 v84, -1
    v_mov_b32 v76, 0
    v_mov_b32 v85, -1
    v_mov_b32 v77, 0
    v_mov_b32 v86, -1
    v_mov_b32 v78, 0
    v_mov_b32 v87, -1
    v_mov_b32 v79, 0
    ds_write_b128 v157, v[84:87] offset:5632
    v_and_b32 v156, 6, v0
    v_lshlrev_b32 v156, 2, v156
    v_lshl_add_u32 v156, v130, 5, v156
    v_lshl_add_u32 v156, v126, 9, v156
    s_lshl_b32 s3, s21, 13
    s_lshl_b32 s33, s20, 10
    s_add_u32 s3, s3, s33
    s_lshl_b32 s33, s23, 5
    s_add_u32 s3, s3, s33
    v_add_u32 v156, s3, v156
    v_lshlrev_b32 v160, 2, v160
    v_lshlrev_b32 v159, 4, v126
    v_sub_u32 v159, 16, v159
    v_mov_b32 v132, 0xffff0000
    v_lshrrev_b32 v132, v159, v132
    v_lshrrev_b32 v131, 1, v131
    v_cmp_eq_u32 s[68:69], 0, v131
    v_cmp_eq_u32 s[70:71], 1, v131
    v_cmp_eq_u32 s[72:73], 2, v131
    v_cmp_eq_u32 s[74:75], 3, v131
    v_cndmask_b32 v56, 0, v132, s[68:69]
    v_cndmask_b32 v57, 0, v132, s[70:71]
    v_cndmask_b32 v58, 0, v132, s[72:73]
    v_cndmask_b32 v59, 0, v132, s[74:75]
    v_lshlrev_b32 v126, 2, v126
    s_mov_b32 s61, 65536
    s_mov_b32 s58, 0x55555555
    s_mov_b32 s59, 0xaaaaaaaa
    s_waitcnt lgkmcnt(0)
    ds_bpermute_b32 v144, v155, v154 offset:0
    ds_bpermute_b32 v145, v155, v154 offset:16
    ds_bpermute_b32 v146, v155, v154 offset:32
    v_add_u32 v155, 48, v155
    s_sub_i32 s47, s47, 12
    s_movk_i32 s3, 1152
    s_waitcnt lgkmcnt(0)
    v_subrev_u32 v144, 1, v144
    v_and_b32 v147, 31, v144
    v_lshl_add_u32 v147, v147, 3, v160
    v_mad_i32_i24 v144, v144, s3, v158
    v_subrev_u32 v145, 1, v145
    v_and_b32 v148, 31, v145
    v_lshl_add_u32 v148, v148, 3, v160
    v_mad_i32_i24 v145, v145, s3, v158
    v_subrev_u32 v146, 1, v146
    v_and_b32 v149, 31, v146
    v_lshl_add_u32 v149, v149, 3, v160
    v_mad_i32_i24 v146, v146, s3, v158
    s_cmp_lg_u32 s22, 0
    s_cbranch_scc1 L_kc_b
    buffer_load_dwordx4 v[96:99], v29, s[28:31], 0 offen offset:1024 sc1
L_kc_rec:
    s_waitcnt vmcnt(0)
    v_cmp_ne_u32 vcc, v97, v141
    v_cmp_ne_u32 s[34:35], v99, v141
    s_nop 0
    s_or_b64 vcc, vcc, s[34:35]
    s_and_b64 vcc, vcc, s[52:53]
    s_cbranch_scc1 L_kc_rerec
L_kc_recok:
    v_cmp_eq_u32 vcc, 24, v100
    v_mov_b32 v128, 0xf149f2ca
    v_cndmask_b32 v96, v128, v96, s[52:53]
    v_cndmask_b32 v96, v96, v140, vcc
    v_cndmask_b32 v98, v98, v142, vcc
    v_mov_b32 v128, v96
    s_nop 1
    v_max_f32_dpp v128, v128, v128 row_ror:2 row_mask:0xf bank_mask:0xf
    s_nop 1
    v_max_f32_dpp v128, v128, v128 row_ror:4 row_mask:0xf bank_mask:0xf
    s_nop 1
    v_max_f32_dpp v128, v128, v128 row_ror:8 row_mask:0xf bank_mask:0xf
    v_mov_b32 v129, v128
    s_nop 1
    v_permlane16_swap_b32 v128, v129
    v_max_f32 v128, v128, v129
    v_mov_b32 v129, v128
    s_nop 1
    v_permlane32_swap_b32 v128, v129
    v_max_f32 v128, v128, v129
    v_sub_f32 v96, v96, v128
    v_exp_f32 v96, v96
    s_nop 0
    v_mul_f32 v128, v96, v98
    s_nop 1
    v_add_f32_dpp v128, v128, v128 row_ror:2 row_mask:0xf bank_mask:0xf
    s_nop 1
    v_add_f32_dpp v128, v128, v128 row_ror:4 row_mask:0xf bank_mask:0xf
    s_nop 1
    v_add_f32_dpp v128, v128, v128 row_ror:8 row_mask:0xf bank_mask:0xf
    v_mov_b32 v129, v128
    s_nop 1
    v_permlane16_swap_b32 v128, v129
    v_add_f32 v128, v128, v129
    v_mov_b32 v129, v128
    s_nop 1
    v_permlane32_swap_b32 v128, v129
    v_add_f32 v128, v128, v129
    v_rcp_f32 v128, v128
    v_lshlrev_b32 v129, 2, v0
    v_mul_f32 v96, v96, v128
    ds_write_b32 v129, v96 offset:5376
    s_waitcnt lgkmcnt(0)
L_kc_b:
    s_barrier
    buffer_load_dwordx4 v[64:67], v144, s[28:31], 0 offen sc1
    buffer_load_dwordx4 v[68:71], v145, s[28:31], 0 offen sc1
    buffer_load_dwordx4 v[72:75], v146, s[28:31], 0 offen sc1
    ds_read_b32 v150, v147 offset:5376
    ds_read_b32 v151, v148 offset:5376
    ds_read_b32 v152, v149 offset:5376
    ds_read_b32 v162, v126 offset:5568
L_kc_w:
    s_waitcnt lgkmcnt(0)
    v_and_b32 v128, 0xffff0000, v150
    v_sub_f32 v129, v150, v128
    v_lshrrev_b32 v128, v159, v128
    v_lshrrev_b32 v129, v159, v129
    v_and_b32 v32, v56, v128
    v_and_b32 v44, v56, v129
    v_and_b32 v33, v57, v128
    v_and_b32 v45, v57, v129
    v_and_b32 v34, v58, v128
    v_and_b32 v46, v58, v129
    v_and_b32 v35, v59, v128
    v_and_b32 v47, v59, v129
    v_and_b32 v128, 0xffff0000, v151
    v_sub_f32 v129, v151, v128
    v_lshrrev_b32 v128, v159, v128
    v_lshrrev_b32 v129, v159, v129
    v_and_b32 v36, v56, v128
    v_and_b32 v48, v56, v129
    v_and_b32 v37, v57, v128
    v_and_b32 v49, v57, v129
    v_and_b32 v38, v58, v128
    v_and_b32 v50, v58, v129
    v_and_b32 v39, v59, v128
    v_and_b32 v51, v59, v129
    v_and_b32 v128, 0xffff0000, v152
    v_sub_f32 v129, v152, v128
    v_lshrrev_b32 v128, v159, v128
    v_lshrrev_b32 v129, v159, v129
    v_and_b32 v40, v56, v128
    v_and_b32 v52, v56, v129
    v_and_b32 v41, v57, v128
    v_and_b32 v53, v57, v129
    v_and_b32 v42, v58, v128
    v_and_b32 v54, v58, v129
    v_and_b32 v43, v59, v128
    v_and_b32 v55, v59, v129
L_kc_poll:
    s_waitcnt vmcnt(0)
    v_mfma_f32_16x16x32_bf16 v[80:83], v[32:35], v[64:67], v[76:79]
    v_max3_u32 v131, v64, v65, v66
    v_max3_u32 v132, v68, v69, v70
    v_max3_u32 v133, v72, v73, v74
    v_mfma_f32_16x16x32_bf16 v[80:83], v[44:47], v[64:67], v[80:83]
    v_max_u32 v131, v131, v67
    v_max_u32 v132, v132, v71
    v_max_u32 v133, v133, v75
    v_mfma_f32_16x16x32_bf16 v[80:83], v[36:39], v[68:71], v[80:83]
    v_cmp_eq_u32 s[68:69], -1, v131
    v_cmp_eq_u32 s[70:71], -1, v132
    v_cmp_eq_u32 s[72:73], -1, v133
    ds_read_b128 v[84:87], v157 offset:5632
    v_mfma_f32_16x16x32_bf16 v[80:83], v[48:51], v[68:71], v[80:83]
    s_or_b64 vcc, s[68:69], s[70:71]
    s_or_b64 vcc, vcc, s[72:73]
    s_cbranch_scc1 L_kc_again
L_kc_got:
    v_mfma_f32_16x16x32_bf16 v[80:83], v[40:43], v[72:75], v[80:83]
    s_cmp_gt_i32 s47, 0
    v_mfma_f32_16x16x32_bf16 v[80:83], v[52:55], v[72:75], v[80:83]
    s_cbranch_scc1 L_kc_chunk
    s_waitcnt lgkmcnt(0)
    v_max3_u32 v130, v84, v85, v86
    v_max_u32 v130, v130, v87
    v_cmp_eq_u32 vcc, -1, v130
    s_nop 0
    s_cbranch_vccnz L_kc_own
    s_mov_b64 exec, s[58:59]
    v_pk_fma_f32 v[80:81], v[84:85], v[162:163], v[80:81] op_sel_hi:[1,0,1]
    v_pk_fma_f32 v[82:83], v[86:87], v[162:163], v[82:83] op_sel_hi:[1,0,1]
    v_cvt_pk_bf16_f32 v80, v80, v81
    v_cvt_pk_bf16_f32 v81, v82, v83
    global_store_dwordx2 v156, v[80:81], s[14:15]
    s_endpgm
L_kc_own:
    ds_read_b128 v[84:87], v157 offset:5632
    s_sub_u32 s61, s61, 1
    s_cselect_b64 s[34:35], 0, -1
    s_waitcnt lgkmcnt(0)
    v_max3_u32 v130, v84, v85, v86
    v_max_u32 v130, v130, v87
    v_cmp_eq_u32 vcc, -1, v130
    s_nop 0
    s_and_b64 vcc, vcc, s[34:35]
    s_cbranch_scc1 L_kc_own
    s_mov_b64 exec, s[58:59]
    v_pk_fma_f32 v[80:81], v[84:85], v[162:163], v[80:81] op_sel_hi:[1,0,1]
    v_pk_fma_f32 v[82:83], v[86:87], v[162:163], v[82:83] op_sel_hi:[1,0,1]
    v_cvt_pk_bf16_f32 v80, v80, v81
    v_cvt_pk_bf16_f32 v81, v82, v83
    global_store_dwordx2 v156, v[80:81], s[14:15]
    s_endpgm
L_hop2:
    s_branch L_v
L_kc_again:
    s_mov_b64 exec, s[68:69]
    s_cbranch_execz L_rl0
    buffer_load_dwordx4 v[64:67], v144, s[28:31], 0 offen sc1
L_rl0:
    s_mov_b64 exec, s[70:71]
    s_cbranch_execz L_rl1
    buffer_load_dwordx4 v[68:71], v145, s[28:31], 0 offen sc1
L_rl1:
    s_mov_b64 exec, s[72:73]
    s_cbranch_execz L_rl2
    buffer_load_dwordx4 v[72:75], v146, s[28:31], 0 offen sc1
L_rl2:
    s_mov_b64 exec, -1
    s_sub_u32 s37, s37, 1
    s_cbranch_scc0 L_kc_poll
    s_mov_b32 s37, 0
    s_branch L_kc_got
L_kc_rerec:
    s_sub_u32 s37, s37, 1
    s_cbranch_scc1 L_kc_giveup
    buffer_load_dwordx4 v[96:99], v29, s[28:31], 0 offen offset:1024 sc1
    s_branch L_kc_rec
L_kc_giveup:
    s_mov_b32 s37, 0
    s_branch L_kc_recok
L_v:
    s_load_dwordx16 s[4:19], s[0:1], 0
    s_setprio 3
    s_and_b32 s20, s2, 7
    s_lshr_b32 s21, s2, 3
    v_and_b32 v0, 63, v0
    v_and_b32 v1, 15, v0
    v_lshrrev_b32 v2, 4, v0
    v_lshrrev_b32 v3, 1, v1
    s_bfe_u32 s23, s22, 0x40004
    s_cbranch_scc1 L_v_setup
    v_lshlrev_b32 v112, 3, v0
    v_lshlrev_b32 v113, 2, v3
    s_waitcnt lgkmcnt(0)
    global_load_dwordx2 v[128:129], v112, s[10:11] offset:0
    global_load_dwordx2 v[130:131], v112, s[10:11] offset:512
    global_load_dwordx2 v[132:133], v112, s[10:11] offset:1024
    global_load_dwordx2 v[134:135], v112, s[10:11] offset:1536
    global_load_dwordx2 v[136:137], v112, s[10:11] offset:2048
    global_load_dwordx2 v[138:139], v112, s[10:11] offset:2560
    global_load_dwordx2 v[140:141], v112, s[10:11] offset:3072
    global_load_dwordx2 v[142:143], v112, s[10:11] offset:3584
    global_load_dword v7, v113, s[12:13]
L_v_setup:
    s_waitcnt lgkmcnt(0)
    s_mul_i32 s3, s20, 221184
    s_mul_i32 s33, s21, 27648
    s_sub_u32 s34, s21, 8
    s_mulk_i32 s34, 1152
    s_mov_b32 s30, 194688
    s_cmp_lt_u32 s21, 8
    s_cselect_b32 s33, s33, s34
    s_cselect_b32 s30, 27648, s30
    s_add_u32 s3, s3, s33
    s_add_u32 s28, s18, s3
    s_addc_u32 s29, s19, 0
    s_mov_b32 s31, 0x20000
    s_cmp_lt_u32 s21, 8
    s_cselect_b32 s61, s23, 0
    s_cmp_eq_u32 s61, 8
    s_cbranch_scc0 L_v_noarm
    v_lshrrev_b32 v121, 1, v0
    v_and_b32 v122, 1, v0
    v_lshlrev_b32 v122, 4, v122
    s_movk_i32 s3, 1152
    v_mad_u32_u24 v121, v121, s3, v122
    buffer_load_dwordx4 v[64:67], v121, s[28:31], 0 offen offset:1024 sc1
L_v_noarm:
    s_setprio 0
    s_mov_b64 s[24:25], s[8:9]
    s_mov_b32 s27, 0x20000
    v_lshrrev_b32 v121, 3, v0
    v_and_b32 v122, 6, v121
    v_and_b32 v123, 7, v0
    v_xor_b32 v122, v122, v123
    v_lshlrev_b32 v122, 4, v122
    v_lshl_or_b32 v122, v121, 12, v122
    s_lshl_b32 s3, s20, 9
    s_lshl_b32 s33, s23, 5
    s_add_u32 s3, s3, s33
    v_add_u32 v12, s3, v122
    v_add_u32 v13, 31744, v12
    s_lshl_b32 s63, s23, 9
    s_addk_i32 s63, 7680
    v_lshrrev_b32 v121, 2, v0
    v_bfe_u32 v122, v0, 3, 2
    v_lshlrev_b32 v122, 5, v122
    v_lshl_or_b32 v122, v121, 7, v122
    v_and_b32 v121, 3, v0
    v_lshl_or_b32 v122, v121, 3, v122
    v_xor_b32 v14, 0, v122
    v_add_u32 v14, s63, v14
    v_add_u32 v18, 0x10000, v14
    v_xor_b32 v15, 32, v122
    v_add_u32 v15, s63, v15
    v_add_u32 v19, 0x10000, v15
    v_xor_b32 v16, 64, v122
    v_add_u32 v16, s63, v16
    v_add_u32 v20, 0x10000, v16
    v_xor_b32 v17, 96, v122
    v_add_u32 v17, s63, v17
    v_add_u32 v21, 0x10000, v17
    v_mov_b32 v96, 0
    v_mov_b32 v97, 0
    v_mov_b32 v98, 0
    v_mov_b32 v99, 0
    v_mov_b32 v100, 0
    v_mov_b32 v101, 0
    v_mov_b32 v102, 0
    v_mov_b32 v103, 0
    v_mov_b32 v104, 0
    v_mov_b32 v105, 0
    v_mov_b32 v106, 0
    v_mov_b32 v107, 0
    v_mov_b32 v108, 0
    v_mov_b32 v109, 0
    v_mov_b32 v110, 0
    v_mov_b32 v111, 0
    v_lshlrev_b32 v28, 5, v1
    v_lshlrev_b32 v29, 4, v0
    v_add_u32 v29, 155136, v29
    v_and_b32 v30, 1, v0
    v_lshlrev_b32 v30, 4, v30
    v_lshl_add_u32 v30, v2, 5, v30
    s_movk_i32 s3, 27648
    v_mad_u32_u24 v31, v3, s3, v30
    s_lshl_b32 s3, s23, 6
    v_add_u32 v31, s3, v31
    s_lshl_b32 s3, s23, 7
    v_add_u32 v30, s3, v30
    s_mov_b32 s62, 1
    s_mov_b32 s60, 0
    s_waitcnt vmcnt(0)
    s_cmp_eq_u32 s61, 8
    s_cbranch_scc0 L_v_noflag
    s_getreg_b32 s33, hwreg(HW_REG_XCC_ID, 0, 4)
    s_add_u32 s33, s33, 1
L_v_nonce:
    s_addk_i32 s33, 0x100
    v_cmp_eq_u32 vcc, s33, v65
    v_cmp_eq_u32 s[34:35], s33, v67
    s_nop 0
    s_or_b64 vcc, vcc, s[34:35]
    s_cbranch_scc1 L_v_nonce
    s_lshl3_add_u32 s3, s20, s21
    s_lshl_b32 s3, s3, 2
    v_mov_b32 v121, s3
    v_mov_b32 v122, s33
    v_mov_b32 v123, 0
    s_mov_b64 exec, 1
    s_setprio 3
    global_store_dword v121, v122, s[16:17] sc1
    s_setprio 0
    ds_write_b32 v123, v122 offset:5252
    s_mov_b64 exec, -1
    s_waitcnt lgkmcnt(0)
L_v_noflag:
    s_cmp_lg_u32 s23, 0
    s_cbranch_scc1 L_vbq
    ds_write_b64 v112, v[128:129] offset:0
    ds_write_b64 v112, v[130:131] offset:512
    ds_write_b64 v112, v[132:133] offset:1024
    ds_write_b64 v112, v[134:135] offset:1536
    ds_write_b64 v112, v[136:137] offset:2048
    ds_write_b64 v112, v[138:139] offset:2560
    ds_write_b64 v112, v[140:141] offset:3072
    ds_write_b64 v112, v[142:143] offset:3584
    v_min3_u32 v114, v128, v130, v132
    v_max3_u32 v115, v128, v130, v132
    v_min3_u32 v114, v114, v134, v136
    v_max3_u32 v115, v115, v134, v136
    v_min3_u32 v114, v114, v138, v140
    v_max3_u32 v115, v115, v138, v140
    v_min_u32 v114, v114, v142
    v_max_u32 v115, v115, v142
    v_min3_u32 v116, v129, v131, v133
    v_max3_u32 v117, v129, v131, v133
    v_min3_u32 v116, v116, v135, v137
    v_max3_u32 v117, v117, v135, v137
    v_min3_u32 v116, v116, v139, v141
    v_max3_u32 v117, v117, v139, v141
    v_min_u32 v116, v116, v143
    v_max_u32 v117, v117, v143
    v_cmp_ne_u32 vcc, v114, v115
    v_cmp_ne_u32 s[34:35], v116, v117
    v_cmp_gt_i32 s[48:49], 1, v7
    s_ff1_i32_b64 s3, vcc
    s_ff1_i32_b64 s33, s[34:35]
    s_lshl_b32 s3, s3, 1
    s_lshl1_add_u32 s33, s33, 1
    s_min_u32 s3, s3, s33
    v_mov_b32 v117, 0x800
    v_min_i32 v7, v7, v117
    v_mov_b32 v8, 0x3db8aa3b
    v_cndmask_b32 v7, v7, v117, s[48:49]
    v_cndmask_b32 v8, v8, 0, s[48:49]
    s_nop 0
    v_max_i32_dpp v118, v7, v7 row_ror:2 row_mask:0xf bank_mask:0xf
    v_add_u32 v27, 15, v7
    v_lshrrev_b32 v27, 4, v27
    v_max_i32_dpp v118, v118, v118 row_ror:4 row_mask:0xf bank_mask:0xf
    s_nop 1
    v_max_i32_dpp v118, v118, v118 row_ror:8 row_mask:0xf bank_mask:0xf
    v_add_u32 v22, 15, v118
    v_lshrrev_b32 v22, 4, v22
    v_readfirstlane_b32 s42, v118
    v_min_u32 v22, s3, v22
    v_sub_u32 v27, v27, v22
    v_max_i32 v27, 0, v27
    v_readfirstlane_b32 s36, v22
    v_lshlrev_b32 v116, 4, v22
    v_sub_u32 v117, v7, v116
    v_max_i32 v117, 0, v117
    s_nop 1
    v_add_u32_dpp v115, v117, v117 row_ror:2 row_mask:0xf bank_mask:0xf
    s_nop 1
    v_add_u32_dpp v115, v115, v115 row_ror:4 row_mask:0xf bank_mask:0xf
    s_nop 1
    v_add_u32_dpp v115, v115, v115 row_ror:8 row_mask:0xf bank_mask:0xf
    v_add_u32 v115, v115, v116
    v_lshrrev_b32 v115, 5, v115
    v_add_u32 v119, 1, v3
    v_and_b32 v119, 8, v119
    v_sub_u32 v115, v115, v119
    v_add_u32 v115, 20, v115
    v_sub_u32 v117, v117, v115
    v_max_i32 v117, 0, v117
    v_add_u32 v144, v116, v117
    v_add_u32 v26, 15, v117
    v_lshrrev_b32 v26, 4, v26
    s_nop 1
    v_add_u32_dpp v24, v26, v26 row_shr:2 row_mask:0xf bank_mask:0xf bound_ctrl:1
    s_nop 1
    v_add_u32_dpp v24, v24, v24 row_shr:4 row_mask:0xf bank_mask:0xf bound_ctrl:1
    s_nop 1
    v_add_u32_dpp v24, v24, v24 row_shr:8 row_mask:0xf bank_mask:0xf bound_ctrl:1
    v_add_u32 v24, v24, v22
    v_sub_u32 v23, v24, v26
    v_readlane_b32 s38, v24, 15
    v_lshlrev_b32 v25, 4, v23
    v_add3_u32 v25, v25, v3, 1
    v_sub_u32 v25, 0, v25
    s_mul_i32 s38, s38, 43691
    s_mov_b32 s41, 0
    s_and_b32 s3, s21, 7
    s_lshl_b32 s3, s3, 1
    v_mul_lo_u32 v115, v0, s38
    v_readlane_b32 s33, v23, s3
    v_readlane_b32 s37, v24, s3
    v_add_u32 v116, s38, v115
    v_lshrrev_b32 v115, 16, v115
    v_lshrrev_b32 v116, 16, v116
    v_cmp_lt_u32 s[50:51], v115, v116
    v_lshrrev_b32 v115, 4, v115
    v_add_u32 v116, 15, v116
    v_lshrrev_b32 v116, 4, v116
    v_cmp_gt_u32 vcc, s37, v115
    v_cmp_lt_u32 s[34:35], s33, v116
    v_cmp_lt_u32 s[48:49], v115, v22
    s_and_b32 s33, vcc_lo, s34
    s_or_b32 s33, s33, s48
    s_and_b32 s33, s33, s50
    s_and_b32 s33, s33, 0xffffff
    v_mov_b32 v10, s33
    s_cmp_lt_u32 s21, 8
    s_cbranch_scc1 L_plan_c
    s_sub_u32 s3, s21, 8
    s_mul_i32 s56, s3, s38
    s_add_u32 s57, s56, s38
    s_lshr_b32 s56, s56, 16
    s_lshr_b32 s57, s57, 16
    s_lshr_b32 s39, s56, 4
    s_add_u32 s37, s57, 15
    s_lshr_b32 s37, s37, 4
    s_sub_u32 s43, s37, s39
    s_cmp_lt_u32 s56, s57
    s_cselect_b32 s43, s43, 0
    v_cmp_lt_u32 vcc, s39, v24
    v_cmp_gt_u32 s[34:35], s37, v23
    s_nop 0
    s_and_b64 vcc, vcc, s[34:35]
    s_cmp_lt_u32 s39, s36
    s_cselect_b64 vcc, -1, vcc
    s_cmp_lg_u32 s43, 0
    s_cselect_b64 vcc, vcc, 0
    v_cndmask_b32_e64 v9, 0, 1, vcc
    s_branch L_round
L_plan_c:
    v_readlane_b32 s56, v117, s3
    v_readlane_b32 s43, v27, s3
    v_mov_b32 v144, v7
    v_cmp_eq_u32 s[52:53], s21, v3
    s_lshr_b32 s39, s56, 4
    s_sub_u32 s43, s43, s39
    s_movk_i32 s57, 0x7fff
    v_cndmask_b32 v9, 0, 1, s[52:53]
L_round:
    s_sub_u32 s3, s43, s41
    s_cmp_gt_u32 s3, 16
    s_cselect_b32 s33, 1, 0
    v_mov_b32 v11, s33
    s_min_u32 s3, s3, 16
    s_sub_u32 s3, 16, s3
    v_cmp_le_u32 s[34:35], s3, v1
    v_subrev_u32 v112, s3, v1
    v_max_i32 v112, 0, v112
    s_add_u32 s3, s39, s41
    v_add_lshl_u32 v112, v112, s3, 4
    v_sub_u32 v121, s56, v112
    v_max_i32 v121, 0, v121
    v_sub_u32 v122, s57, v112
    v_or_b32 v112, 15, v112
    s_add_u32 s41, s41, 16
    s_cmp_lt_u32 s21, 8
    s_cbranch_scc0 L_round_p
    s_add_u32 s3, s21, 1
    v_subrev_u32 v112, s3, v112
    s_branch L_round_j
L_round_p:
    v_add_u32_dpp v113, v25, v112 row_newbcast:0 row_mask:0xf bank_mask:0xf
    v_add_u32_dpp v114, v25, v112 row_newbcast:2 row_mask:0xf bank_mask:0xf
    v_add_u32_dpp v115, v25, v112 row_newbcast:4 row_mask:0xf bank_mask:0xf
    v_add_u32_dpp v116, v25, v112 row_newbcast:6 row_mask:0xf bank_mask:0xf
    v_add_u32_dpp v117, v25, v112 row_newbcast:8 row_mask:0xf bank_mask:0xf
    v_add_u32_dpp v118, v25, v112 row_newbcast:10 row_mask:0xf bank_mask:0xf
    v_add_u32_dpp v119, v25, v112 row_newbcast:12 row_mask:0xf bank_mask:0xf
    v_add_u32_dpp v120, v25, v112 row_newbcast:14 row_mask:0xf bank_mask:0xf
    v_min3_u32 v112, v112, v113, v114
    v_min3_u32 v115, v115, v116, v117
    v_min3_u32 v118, v118, v119, v120
    v_min3_u32 v112, v112, v115, v118
L_round_j:
    v_and_b32 v113, 15, v112
    v_lshrrev_b32 v112, 4, v112
    v_sub_u32 v113, 15, v113
    v_min_u32 v114, 1, v113
    v_mad_u32_u24 v112, v114, v22, v112
    v_min_u32 v112, 0x7f, v112
    v_sub_u32 v114, v113, v114
    v_lshlrev_b32 v115, 2, v112
    v_lshl_add_u32 v115, v114, 9, v115
    v_lshlrev_b32 v116, 3, v114
    ds_bpermute_b32 v5, v116, v144
    ds_read_b32 v4, v115 offset:0
    v_lshlrev_b32 v112, 4, v112
    v_cmp_eq_u32 vcc, 0, v113
    v_mov_b32 v116, s42
    s_waitcnt lgkmcnt(1)
    v_cndmask_b32 v5, v5, v116, vcc
    v_sub_u32 v5, v5, v112
    v_min_i32 v5, v5, v122
    v_med3_i32 v5, v5, v121, 16
    v_add_u32 v112, v112, v121
    v_sub_u32 v118, v5, v121
    v_lshl_or_b32 v112, v112, 5, v118
    v_lshl_or_b32 v112, v112, 4, v113
    v_cndmask_b32 v6, 0, v112, s[34:35]
    s_waitcnt lgkmcnt(0)
    v_ashrrev_i32 v118, 31, v4
    v_and_b32 v118, 576, v118
    v_add_u32 v4, v4, v118
    v_min_u32 v4, 575, v4
    v_lshlrev_b32 v4, 16, v4
    v_lshl_add_u32 v5, v5, 12, v4
    v_lshl_add_u32 v4, v121, 12, v4
    v_cndmask_b32 v5, 0, v5, s[34:35]
    v_cndmask_b32 v4, 0, v4, s[34:35]
    ds_write_b128 v28, v[4:7] offset:4096
    ds_write_b128 v28, v[8:11] offset:4112
    s_cmp_eq_u32 s62, 0
    s_cbranch_scc1 L_vx
L_vinit:
    v_lshlrev_b32 v112, 2, v0
    v_mov_b32 v113, -1
    v_mov_b32 v114, 0
    ds_write_b32 v112, v113 offset:4608
    ds_write_b32 v114, v114 offset:5248
    s_waitcnt lgkmcnt(0)
    s_branch L_vbq
.p2align 12
L_vbq:
    s_barrier
    ds_read_b64 v[4:5], v28 offset:4096
    ds_read_b128 v[8:11], v28 offset:4112
    v_mov_b32 v114, 0
    s_waitcnt lgkmcnt(1)
    v_readlane_b32 s48, v4, 4
    v_readlane_b32 s50, v5, 4
    v_readlane_b32 s49, v4, 5
    v_readlane_b32 s51, v5, 5
    s_mov_b32 m0, s63
    s_mov_b32 s26, s50
    buffer_load_dwordx4 v12, s[24:27], s48 offen nt lds
    buffer_load_dwordx4 v13, s[24:27], s48 offen offset:1024 nt lds
    v_readlane_b32 s48, v4, 0
    v_readlane_b32 s50, v5, 0
    s_add_u32 m0, s63, 8192
    s_mov_b32 s26, s51
    buffer_load_dwordx4 v12, s[24:27], s49 offen nt lds
    buffer_load_dwordx4 v13, s[24:27], s49 offen offset:1024 nt lds
    s_waitcnt lgkmcnt(0)
    v_cmp_ne_u32 s[44:45], 0, v9
    v_readfirstlane_b32 s40, v11
    s_cmp_lt_u32 s21, 8
    s_cselect_b32 s3, 0, s62
    s_mov_b32 s62, 0
    s_cmp_eq_u32 s3, 0
    s_cbranch_scc1 L_vb0
    v_lshlrev_b32 v116, 1, v2
    v_lshrrev_b32 v116, v116, s44
    v_and_b32 v117, 1, v116
    v_bfe_u32 v116, v116, 8, 1
    v_cmp_ne_u32 vcc, 0, v117
    v_cmp_ne_u32 s[34:35], 0, v116
    v_lshlrev_b32 v117, 4, v1
    s_movk_i32 s3, 27648
    v_mad_u32_u24 v116, v2, s3, v117
    v_mov_b32 v64, -1
    v_mov_b32 v65, -1
    v_mov_b32 v66, -1
    v_mov_b32 v67, -1
    s_lshl_b32 s3, s23, 6
    s_mov_b64 exec, vcc
    s_cbranch_execz L_v_clr0
    buffer_store_dwordx4 v[64:67], v116, s[28:31], s3 offen
L_v_clr0:
    s_add_u32 s3, s3, 110592
    s_mov_b64 exec, s[34:35]
    s_cbranch_execz L_v_clr1
    buffer_store_dwordx4 v[64:67], v116, s[28:31], s3 offen
L_v_clr1:
    s_mov_b64 exec, -1
L_vb0:
    s_barrier
    ds_read_b32 v115, v114 offset:5248
    v_readlane_b32 s49, v4, 1
    v_readlane_b32 s51, v5, 1
    s_add_u32 m0, s63, 16384
    s_mov_b32 s26, s50
    buffer_load_dwordx4 v12, s[24:27], s48 offen nt lds
    buffer_load_dwordx4 v13, s[24:27], s48 offen offset:1024 nt lds
    s_waitcnt lgkmcnt(0)
    v_cmp_ne_u32 vcc, 0, v115
    s_nop 0
    s_cbranch_vccnz L_vx
    v_readlane_b32 s48, v4, 2
    v_readlane_b32 s50, v5, 2
    s_add_u32 m0, s63, 24576
    s_mov_b32 s26, s51
    buffer_load_dwordx4 v12, s[24:27], s49 offen nt lds
    buffer_load_dwordx4 v13, s[24:27], s49 offen offset:1024 nt lds
    v_readlane_b32 s49, v4, 3
    v_readlane_b32 s51, v5, 3
    s_add_u32 m0, s63, 32768
    s_mov_b32 s26, s50
    buffer_load_dwordx4 v12, s[24:27], s48 offen nt lds
    buffer_load_dwordx4 v13, s[24:27], s48 offen offset:1024 nt lds
    v_readlane_b32 s48, v4, 6
    v_readlane_b32 s50, v5, 6
    s_add_u32 m0, s63, 40960
    s_mov_b32 s26, s51
    buffer_load_dwordx4 v12, s[24:27], s49 offen nt lds
    buffer_load_dwordx4 v13, s[24:27], s49 offen offset:1024 nt lds
    v_readlane_b32 s49, v4, 7
    v_readlane_b32 s51, v5, 7
    s_add_u32 m0, s63, 49152
    s_mov_b32 s26, s50
    buffer_load_dwordx4 v12, s[24:27], s48 offen nt lds
    buffer_load_dwordx4 v13, s[24:27], s48 offen offset:1024 nt lds
    v_readlane_b32 s48, v4, 8
    v_readlane_b32 s50, v5, 8
    s_add_u32 m0, s63, 57344
    s_mov_b32 s26, s51
    buffer_load_dwordx4 v12, s[24:27], s49 offen nt lds
    buffer_load_dwordx4 v13, s[24:27], s49 offen offset:1024 nt lds
    v_readlane_b32 s49, v4, 9
    v_readlane_b32 s51, v5, 9
    s_add_u32 m0, s63, 65536
    s_mov_b32 s26, s50
    buffer_load_dwordx4 v12, s[24:27], s48 offen nt lds
    buffer_load_dwordx4 v13, s[24:27], s48 offen offset:1024 nt lds
    v_readlane_b32 s48, v4, 10
    v_readlane_b32 s50, v5, 10
    s_add_u32 m0, s63, 73728
    s_mov_b32 s26, s51
    buffer_load_dwordx4 v12, s[24:27], s49 offen nt lds
    buffer_load_dwordx4 v13, s[24:27], s49 offen offset:1024 nt lds
    v_readlane_b32 s49, v4, 11
    v_readlane_b32 s51, v5, 11
    s_add_u32 m0, s63, 81920
    s_mov_b32 s26, s50
    buffer_load_dwordx4 v12, s[24:27], s48 offen nt lds
    buffer_load_dwordx4 v13, s[24:27], s48 offen offset:1024 nt lds
    s_waitcnt vmcnt(18)
    s_barrier
    ds_read_b128 v[32:35], v29 offset:2048
    ds_read_b128 v[36:39], v29 offset:0
    ds_read_b128 v[40:43], v29 offset:1024
    ds_read_b128 v[44:47], v29 offset:3072
    ds_read_b128 v[48:51], v29 offset:4096
    ds_read_b128 v[52:55], v29 offset:5120
    ds_read_b128 v[56:59], v29 offset:6144
    ds_read_b128 v[60:63], v29 offset:7168
    v_readlane_b32 s48, v4, 12
    v_readlane_b32 s50, v5, 12
    s_add_u32 m0, s63, 90112
    s_mov_b32 s26, s51
    buffer_load_dwordx4 v12, s[24:27], s49 offen nt lds
    buffer_load_dwordx4 v13, s[24:27], s49 offen offset:1024 nt lds
    s_cmp_lg_u32 s60, 0
    s_cbranch_scc1 L_vscale
L_vpv:
    s_waitcnt vmcnt(20) lgkmcnt(0)
    ds_read_b64_tr_b16 v[64:65], v14 offset:0
    ds_read_b64_tr_b16 v[68:69], v15 offset:0
    ds_read_b64_tr_b16 v[72:73], v16 offset:0
    ds_read_b64_tr_b16 v[76:77], v17 offset:0
    ds_read_b64_tr_b16 v[66:67], v14 offset:8192
    ds_read_b64_tr_b16 v[70:71], v15 offset:8192
    ds_read_b64_tr_b16 v[74:75], v16 offset:8192
    ds_read_b64_tr_b16 v[78:79], v17 offset:8192
    s_waitcnt lgkmcnt(3)
    v_mfma_f32_16x16x32_bf16 v[96:99], v[64:67], v[32:35], v[96:99]
    s_waitcnt lgkmcnt(2)
    v_mfma_f32_16x16x32_bf16 v[100:103], v[68:71], v[32:35], v[100:103]
    s_waitcnt lgkmcnt(1)
    v_mfma_f32_16x16x32_bf16 v[104:107], v[72:75], v[32:35], v[104:107]
    s_waitcnt lgkmcnt(0)
    v_mfma_f32_16x16x32_bf16 v[108:111], v[76:79], v[32:35], v[108:111]
    s_waitcnt vmcnt(16)
    ds_read_b64_tr_b16 v[80:81], v14 offset:16384
    ds_read_b64_tr_b16 v[84:85], v15 offset:16384
    ds_read_b64_tr_b16 v[88:89], v16 offset:16384
    ds_read_b64_tr_b16 v[92:93], v17 offset:16384
    ds_read_b64_tr_b16 v[82:83], v14 offset:24576
    ds_read_b64_tr_b16 v[86:87], v15 offset:24576
    ds_read_b64_tr_b16 v[90:91], v16 offset:24576
    ds_read_b64_tr_b16 v[94:95], v17 offset:24576
    s_waitcnt lgkmcnt(3)
    v_mfma_f32_16x16x32_bf16 v[96:99], v[80:83], v[36:39], v[96:99]
    s_waitcnt lgkmcnt(2)
    v_mfma_f32_16x16x32_bf16 v[100:103], v[84:87], v[36:39], v[100:103]
    s_waitcnt lgkmcnt(1)
    v_mfma_f32_16x16x32_bf16 v[104:107], v[88:91], v[36:39], v[104:107]
    s_waitcnt lgkmcnt(0)
    v_mfma_f32_16x16x32_bf16 v[108:111], v[92:95], v[36:39], v[108:111]
    v_readlane_b32 s49, v4, 13
    v_readlane_b32 s51, v5, 13
    s_add_u32 m0, s63, 98304
    s_mov_b32 s26, s50
    buffer_load_dwordx4 v12, s[24:27], s48 offen nt lds
    buffer_load_dwordx4 v13, s[24:27], s48 offen offset:1024 nt lds
    s_waitcnt vmcnt(14)
    ds_read_b64_tr_b16 v[64:65], v14 offset:32768
    ds_read_b64_tr_b16 v[68:69], v15 offset:32768
    ds_read_b64_tr_b16 v[72:73], v16 offset:32768
    ds_read_b64_tr_b16 v[76:77], v17 offset:32768
    ds_read_b64_tr_b16 v[66:67], v14 offset:40960
    ds_read_b64_tr_b16 v[70:71], v15 offset:40960
    ds_read_b64_tr_b16 v[74:75], v16 offset:40960
    ds_read_b64_tr_b16 v[78:79], v17 offset:40960
    s_waitcnt lgkmcnt(3)
    v_mfma_f32_16x16x32_bf16 v[96:99], v[64:67], v[40:43], v[96:99]
    s_waitcnt lgkmcnt(2)
    v_mfma_f32_16x16x32_bf16 v[100:103], v[68:71], v[40:43], v[100:103]
    s_waitcnt lgkmcnt(1)
    v_mfma_f32_16x16x32_bf16 v[104:107], v[72:75], v[40:43], v[104:107]
    s_waitcnt lgkmcnt(0)
    v_mfma_f32_16x16x32_bf16 v[108:111], v[76:79], v[40:43], v[108:111]
    s_waitcnt vmcnt(10)
    ds_read_b64_tr_b16 v[80:81], v14 offset:49152
    ds_read_b64_tr_b16 v[84:85], v15 offset:49152
    ds_read_b64_tr_b16 v[88:89], v16 offset:49152
    ds_read_b64_tr_b16 v[92:93], v17 offset:49152
    ds_read_b64_tr_b16 v[82:83], v14 offset:57344
    ds_read_b64_tr_b16 v[86:87], v15 offset:57344
    ds_read_b64_tr_b16 v[90:91], v16 offset:57344
    ds_read_b64_tr_b16 v[94:95], v17 offset:57344
    s_waitcnt lgkmcnt(3)
    v_mfma_f32_16x16x32_bf16 v[96:99], v[80:83], v[44:47], v[96:99]
    s_waitcnt lgkmcnt(2)
    v_mfma_f32_16x16x32_bf16 v[100:103], v[84:87], v[44:47], v[100:103]
    s_waitcnt lgkmcnt(1)
    v_mfma_f32_16x16x32_bf16 v[104:107], v[88:91], v[44:47], v[104:107]
    s_waitcnt lgkmcnt(0)
    v_mfma_f32_16x16x32_bf16 v[108:111], v[92:95], v[44:47], v[108:111]
    v_readlane_b32 s48, v4, 14
    v_readlane_b32 s50, v5, 14
    s_add_u32 m0, s63, 106496
    s_mov_b32 s26, s51
    buffer_load_dwordx4 v12, s[24:27], s49 offen nt lds
    buffer_load_dwordx4 v13, s[24:27], s49 offen offset:1024 nt lds
    v_readlane_b32 s49, v4, 15
    v_readlane_b32 s51, v5, 15
    s_add_u32 m0, s63, 114688
    s_mov_b32 s26, s50
    buffer_load_dwordx4 v12, s[24:27], s48 offen nt lds
    buffer_load_dwordx4 v13, s[24:27], s48 offen offset:1024 nt lds
    s_waitcnt vmcnt(10)
    ds_read_b64_tr_b16 v[64:65], v18 offset:0
    ds_read_b64_tr_b16 v[68:69], v19 offset:0
    ds_read_b64_tr_b16 v[72:73], v20 offset:0
    ds_read_b64_tr_b16 v[76:77], v21 offset:0
    ds_read_b64_tr_b16 v[66:67], v18 offset:8192
    ds_read_b64_tr_b16 v[70:71], v19 offset:8192
    ds_read_b64_tr_b16 v[74:75], v20 offset:8192
    ds_read_b64_tr_b16 v[78:79], v21 offset:8192
    s_waitcnt lgkmcnt(3)
    v_mfma_f32_16x16x32_bf16 v[96:99], v[64:67], v[48:51], v[96:99]
    s_waitcnt lgkmcnt(2)
    v_mfma_f32_16x16x32_bf16 v[100:103], v[68:71], v[48:51], v[100:103]
    s_waitcnt lgkmcnt(1)
    v_mfma_f32_16x16x32_bf16 v[104:107], v[72:75], v[48:51], v[104:107]
    s_waitcnt lgkmcnt(0)
    v_mfma_f32_16x16x32_bf16 v[108:111], v[76:79], v[48:51], v[108:111]
    s_add_u32 m0, s63, 122880
    s_mov_b32 s26, s51
    buffer_load_dwordx4 v12, s[24:27], s49 offen nt lds
    buffer_load_dwordx4 v13, s[24:27], s49 offen offset:1024 nt lds
    s_setprio 2
    s_waitcnt vmcnt(8)
    ds_read_b64_tr_b16 v[80:81], v18 offset:16384
    ds_read_b64_tr_b16 v[84:85], v19 offset:16384
    ds_read_b64_tr_b16 v[88:89], v20 offset:16384
    ds_read_b64_tr_b16 v[92:93], v21 offset:16384
    ds_read_b64_tr_b16 v[82:83], v18 offset:24576
    ds_read_b64_tr_b16 v[86:87], v19 offset:24576
    ds_read_b64_tr_b16 v[90:91], v20 offset:24576
    ds_read_b64_tr_b16 v[94:95], v21 offset:24576
    s_waitcnt lgkmcnt(3)
    v_mfma_f32_16x16x32_bf16 v[96:99], v[80:83], v[52:55], v[96:99]
    s_waitcnt lgkmcnt(2)
    v_mfma_f32_16x16x32_bf16 v[100:103], v[84:87], v[52:55], v[100:103]
    s_waitcnt lgkmcnt(1)
    v_mfma_f32_16x16x32_bf16 v[104:107], v[88:91], v[52:55], v[104:107]
    s_waitcnt lgkmcnt(0)
    v_mfma_f32_16x16x32_bf16 v[108:111], v[92:95], v[52:55], v[108:111]
    s_waitcnt vmcnt(4)
    ds_read_b64_tr_b16 v[64:65], v18 offset:32768
    ds_read_b64_tr_b16 v[68:69], v19 offset:32768
    ds_read_b64_tr_b16 v[72:73], v20 offset:32768
    ds_read_b64_tr_b16 v[76:77], v21 offset:32768
    ds_read_b64_tr_b16 v[66:67], v18 offset:40960
    ds_read_b64_tr_b16 v[70:71], v19 offset:40960
    ds_read_b64_tr_b16 v[74:75], v20 offset:40960
    ds_read_b64_tr_b16 v[78:79], v21 offset:40960
    s_waitcnt lgkmcnt(3)
    v_mfma_f32_16x16x32_bf16 v[96:99], v[64:67], v[56:59], v[96:99]
    s_waitcnt lgkmcnt(2)
    v_mfma_f32_16x16x32_bf16 v[100:103], v[68:71], v[56:59], v[100:103]
    s_waitcnt lgkmcnt(1)
    v_mfma_f32_16x16x32_bf16 v[104:107], v[72:75], v[56:59], v[104:107]
    s_waitcnt lgkmcnt(0)
    v_mfma_f32_16x16x32_bf16 v[108:111], v[76:79], v[56:59], v[108:111]
    s_waitcnt vmcnt(2)
    s_cmp_lg_u32 s40, 0
    s_cbranch_scc1 L_v_nob
    s_barrier
L_v_nob:
    ds_read_b32 v115, v114 offset:5252
    ds_read_b64_tr_b16 v[80:81], v18 offset:49152
    ds_read_b64_tr_b16 v[84:85], v19 offset:49152
    ds_read_b64_tr_b16 v[88:89], v20 offset:49152
    ds_read_b64_tr_b16 v[92:93], v21 offset:49152
    s_waitcnt lgkmcnt(4)
    v_readfirstlane_b32 s54, v115
    s_cmp_eq_u64 s[44:45], 0
    s_cselect_b32 s54, 0, s54
    s_cmp_lt_u32 s21, 8
    s_cselect_b32 s54, 2, s54
    s_cmp_lg_u32 s40, 0
    s_cselect_b32 s54, 3, s54
    s_cmp_eq_u32 s54, 1
    s_cbranch_scc0 L_v_other
    s_waitcnt vmcnt(0)
    ds_read_b64_tr_b16 v[82:83], v18 offset:57344
    ds_read_b64_tr_b16 v[86:87], v19 offset:57344
    ds_read_b64_tr_b16 v[90:91], v20 offset:57344
    ds_read_b64_tr_b16 v[94:95], v21 offset:57344
    s_waitcnt lgkmcnt(3)
    v_mfma_f32_16x16x32_bf16 v[96:99], v[80:83], v[60:63], v[96:99]
    s_waitcnt lgkmcnt(2)
    v_mfma_f32_16x16x32_bf16 v[100:103], v[84:87], v[60:63], v[100:103]
    s_waitcnt lgkmcnt(1)
    v_mfma_f32_16x16x32_bf16 v[104:107], v[88:91], v[60:63], v[104:107]
    s_waitcnt lgkmcnt(0)
    v_mfma_f32_16x16x32_bf16 v[108:111], v[92:95], v[60:63], v[108:111]
    s_mov_b64 exec, s[44:45]
    s_nop 0
    v_cvt_pk_bf16_f32 v64, v96, v97
    v_cvt_pk_bf16_f32 v65, v98, v99
    v_cvt_pk_bf16_f32 v66, v100, v101
    v_cvt_pk_bf16_f32 v67, v102, v103
    buffer_store_dwordx4 v[64:67], v31, s[28:31], 0 offen
    v_cvt_pk_bf16_f32 v68, v104, v105
    v_cvt_pk_bf16_f32 v69, v106, v107
    v_cvt_pk_bf16_f32 v70, v108, v109
    v_cvt_pk_bf16_f32 v71, v110, v111
    buffer_store_dwordx4 v[68:71], v31, s[28:31], 0 offen offset:128
    s_endpgm
L_v_other:
    s_cmp_eq_u32 s54, 2
    s_cbranch_scc0 L_v_rest
    s_waitcnt vmcnt(0)
    ds_read_b64_tr_b16 v[82:83], v18 offset:57344
    ds_read_b64_tr_b16 v[86:87], v19 offset:57344
    ds_read_b64_tr_b16 v[90:91], v20 offset:57344
    ds_read_b64_tr_b16 v[94:95], v21 offset:57344
    s_waitcnt lgkmcnt(3)
    v_mfma_f32_16x16x32_bf16 v[96:99], v[80:83], v[60:63], v[96:99]
    s_waitcnt lgkmcnt(2)
    v_mfma_f32_16x16x32_bf16 v[100:103], v[84:87], v[60:63], v[100:103]
    s_waitcnt lgkmcnt(1)
    v_mfma_f32_16x16x32_bf16 v[104:107], v[88:91], v[60:63], v[104:107]
    s_waitcnt lgkmcnt(0)
    v_mfma_f32_16x16x32_bf16 v[108:111], v[92:95], v[60:63], v[108:111]
    s_mov_b64 exec, s[44:45]
    s_nop 0
    ds_write_b128 v30, v[96:99] offset:5632
    s_nop 0
    ds_write_b128 v30, v[100:103] offset:5760
    s_nop 0
    ds_write_b128 v30, v[104:107] offset:5888
    s_nop 0
    ds_write_b128 v30, v[108:111] offset:6016
    s_endpgm
L_v_rest:
    s_waitcnt vmcnt(0)
    ds_read_b64_tr_b16 v[82:83], v18 offset:57344
    ds_read_b64_tr_b16 v[86:87], v19 offset:57344
    ds_read_b64_tr_b16 v[90:91], v20 offset:57344
    ds_read_b64_tr_b16 v[94:95], v21 offset:57344
    s_waitcnt lgkmcnt(3)
    v_mfma_f32_16x16x32_bf16 v[96:99], v[80:83], v[60:63], v[96:99]
    s_waitcnt lgkmcnt(2)
    v_mfma_f32_16x16x32_bf16 v[100:103], v[84:87], v[60:63], v[100:103]
    s_waitcnt lgkmcnt(1)
    v_mfma_f32_16x16x32_bf16 v[104:107], v[88:91], v[60:63], v[104:107]
    s_waitcnt lgkmcnt(0)
    v_mfma_f32_16x16x32_bf16 v[108:111], v[92:95], v[60:63], v[108:111]
    s_mov_b64 exec, s[44:45]
    s_cmp_eq_u32 s54, 3
    s_cbranch_scc1 L_vnext
    s_cbranch_execz L_fin
    v_cvt_pk_bf16_f32 v64, v96, v97
    v_cvt_pk_bf16_f32 v65, v98, v99
    v_cvt_pk_bf16_f32 v66, v100, v101
    v_cvt_pk_bf16_f32 v67, v102, v103
    buffer_store_dwordx4 v[64:67], v31, s[28:31], 0 offen sc1
    v_cvt_pk_bf16_f32 v68, v104, v105
    v_cvt_pk_bf16_f32 v69, v106, v107
    v_cvt_pk_bf16_f32 v70, v108, v109
    v_cvt_pk_bf16_f32 v71, v110, v111
    buffer_store_dwordx4 v[68:71], v31, s[28:31], 0 offen offset:128 sc1
    s_endpgm
L_vscale:
    v_lshlrev_b32 v112, 3, v1
    ds_read_b32 v112, v112 offset:5120
    s_waitcnt lgkmcnt(0)
    v_mul_f32 v96, v96, v112
    v_mul_f32 v97, v97, v112
    v_mul_f32 v98, v98, v112
    v_mul_f32 v99, v99, v112
    v_mul_f32 v100, v100, v112
    v_mul_f32 v101, v101, v112
    v_mul_f32 v102, v102, v112
    v_mul_f32 v103, v103, v112
    v_mul_f32 v104, v104, v112
    v_mul_f32 v105, v105, v112
    v_mul_f32 v106, v106, v112
    v_mul_f32 v107, v107, v112
    v_mul_f32 v108, v108, v112
    v_mul_f32 v109, v109, v112
    v_mul_f32 v110, v110, v112
    v_mul_f32 v111, v111, v112
    s_branch L_vpv
L_vnext:
    s_mov_b64 exec, -1
    s_setprio 0
    s_mov_b32 s60, 1
    s_cmp_eq_u32 s23, 0
    s_cbranch_scc1 L_round
L_vx:
    s_waitcnt vmcnt(0) lgkmcnt(0)
    s_barrier
    s_cmp_eq_u32 s23, 0
    s_cbranch_scc1 L_vinit
    s_branch L_vbq
L_kp_far:
    ds_write_b32 v123, v123 offset:5252
    v_mov_b32 v112, -1
    v_mov_b32 v113, -1
    v_mov_b32 v114, -1
    v_mov_b32 v115, -1
    v_lshlrev_b32 v126, 4, v0
    s_and_b32 s33, s44, 0x5555
    s_cbranch_scc0 L_kp_end
L_kclr:
    s_ff1_i32_b32 s3, s33
    s_bitset0_b32 s33, s3
    s_mulk_i32 s3, 13824
    buffer_store_dwordx4 v[112:115], v126, s[28:31], s3 offen sc1
    s_cmp_lg_u32 s33, 0
    s_cbranch_scc1 L_kclr
    s_and_b32 exec_lo, s44, 0xffff
    s_mov_b32 exec_hi, 0
    s_waitcnt vmcnt(0)
    buffer_store_dwordx4 v[140:143], v29, s[28:31], 0 offen offset:1024 sc1
    s_branch L_kp_end
L_kp_reflag:
    s_sub_u32 s37, s37, 1
    s_cbranch_scc1 L_kp_flagok
    global_load_dword v141, v139, s[16:17] sc1
    s_branch L_kp_flag
L_kx:
    s_mov_b32 s62, 0
    s_waitcnt vmcnt(0) lgkmcnt(0)
    s_barrier
    ds_read_b64 v[4:5], v28 offset:4096
    s_mov_b32 s3, s60
    s_waitcnt lgkmcnt(0)
    v_readlane_b32 s48, v4, s3
    v_readlane_b32 s64, v5, s3
    s_add_u32 s3, s3, 4
    v_readlane_b32 s49, v4, s3
    v_readlane_b32 s65, v5, s3
    s_add_u32 s3, s3, 4
    v_readlane_b32 s50, v4, s3
    v_readlane_b32 s66, v5, s3
    s_add_u32 s3, s3, 4
    v_readlane_b32 s51, v4, s3
    v_readlane_b32 s67, v5, s3
    s_cmp_eq_u32 s64, 0
    s_cbranch_scc1 L_ks0
    s_mov_b32 m0, s63
    s_mov_b32 s26, s64
    buffer_load_dwordx4 v12, s[24:27], s48 offen nt lds
    buffer_load_dwordx4 v13, s[24:27], s48 offen offset:1024 nt lds
    buffer_load_dwordx4 v14, s[24:27], s48 offen offset:2048 nt lds
    buffer_load_dwordx4 v15, s[24:27], s48 offen offset:3072 nt lds
    s_addk_i32 m0, 0x1000
    s_nop 0
    buffer_load_dwordx4 v16, s[24:27], s48 offen nt lds
    buffer_load_dwordx4 v17, s[24:27], s48 offen offset:1024 nt lds
    buffer_load_dwordx4 v18, s[24:27], s48 offen offset:2048 nt lds
    buffer_load_dwordx4 v19, s[24:27], s48 offen offset:3072 nt lds
L_ks0:
    s_nop 3
    s_branch L_k12
L_kc_chunk:
    s_waitcnt vmcnt(0) lgkmcnt(0)
    s_nop 7
    v_mov_b32 v76, v80
    v_mov_b32 v77, v81
    v_mov_b32 v78, v82
    v_mov_b32 v79, v83
    ds_bpermute_b32 v144, v155, v154 offset:0
    ds_bpermute_b32 v145, v155, v154 offset:16
    ds_bpermute_b32 v146, v155, v154 offset:32
    v_add_u32 v155, 48, v155
    s_sub_i32 s47, s47, 12
    s_movk_i32 s3, 1152
    s_waitcnt lgkmcnt(0)
    v_subrev_u32 v144, 1, v144
    v_and_b32 v147, 31, v144
    v_lshl_add_u32 v147, v147, 3, v160
    v_mad_i32_i24 v144, v144, s3, v158
    v_subrev_u32 v145, 1, v145
    v_and_b32 v148, 31, v145
    v_lshl_add_u32 v148, v148, 3, v160
    v_mad_i32_i24 v145, v145, s3, v158
    v_subrev_u32 v146, 1, v146
    v_and_b32 v149, 31, v146
    v_lshl_add_u32 v149, v149, 3, v160
    v_mad_i32_i24 v146, v146, s3, v158
    buffer_load_dwordx4 v[64:67], v144, s[28:31], 0 offen sc1
    buffer_load_dwordx4 v[68:71], v145, s[28:31], 0 offen sc1
    buffer_load_dwordx4 v[72:75], v146, s[28:31], 0 offen sc1
    ds_read_b32 v150, v147 offset:5376
    ds_read_b32 v151, v148 offset:5376
    ds_read_b32 v152, v149 offset:5376
    s_branch L_kc_w
L_fin:
L_end:
    s_endpgm
.section .rodata,"a"
.p2align 6
.amdhsa_kernel standalone__paged_block_table_kv_radixattention__sampling_kernel
  .amdhsa_next_free_vgpr 168
  .amdhsa_next_free_sgpr 102
  .amdhsa_accum_offset 168
  .amdhsa_group_segment_fixed_size 0
  .amdhsa_kernarg_size 64
  .amdhsa_user_sgpr_count 2
  .amdhsa_user_sgpr_kernarg_segment_ptr 1
  .amdhsa_system_sgpr_workgroup_id_x 1
.end_amdhsa_kernel
```
